```python
import torch

def _softmax(x, axis=-1):
    return torch.softmax(x, dim=axis)
def _gelu(x):
    return torch.nn.functional.gelu(x, approximate="tanh")
def _silu(x):
    return torch.nn.functional.silu(x)
def _sigmoid(x):
    return torch.sigmoid(x)
def _layernorm(x, axis=-1, eps=1e-5):
    m = x.mean(dim=axis, keepdim=True)
    v = x.var(dim=axis, keepdim=True, unbiased=False)
    return (x - m) / torch.sqrt(v + eps)
def _scatter_add(tgt, idx, src, axis=0):
    return tgt.clone().index_add_(axis, idx, src)
def _segment_sum(src, seg, n):
    out = torch.zeros((n,) + src.shape[1:], dtype=src.dtype)
    return out.index_add_(0, seg, src)
def _pad(x, pw):
    flat = tuple(v for pair in reversed(pw) for v in pair)
    return torch.nn.functional.pad(x, flat)

kernel_name = 'standalone__gqa_softmax__sampling'

def setup_inputs():

    _w = (lambda a: (lambda t: t.to(torch.bfloat16) if t.is_floating_point() else t)(torch.as_tensor(a)))
    B, Hq, Hkv, Sq, Sk, D = 8, 32, 8, 1, 8192, 128
    return {
        "q": _w((lambda *s: torch.randn(*s, dtype=torch.bfloat16) * 0.8)(B, Hq, Sq, D)),
        "k": _w((lambda *s: torch.randn(*s, dtype=torch.bfloat16) * 0.8)(B, Hkv, Sk, D)),
        "v": _w((lambda *s: torch.randn(*s, dtype=torch.bfloat16) * 0.05)(B, Hkv, Sk, D)),
    }

def reference(q, k, v):
    B, Hq, Sq, D = q.shape
    Hkv = k.shape[1]
    rep = Hq // Hkv
    k = (lambda x, n, axis: torch.repeat_interleave(x, n, dim=axis))(k, rep, axis=1)
    v = (lambda x, n, axis: torch.repeat_interleave(x, n, dim=axis))(v, rep, axis=1)
    scale = D ** -0.5
    scores = torch.einsum("bhqd,bhkd->bhqk", q, k) * scale
    p = _softmax(scores, axis=-1)
    return torch.einsum("bhqk,bhkd->bhqd", p, v)
```

```asm
; @launch grid=(256,1,1) block=(320,1,1) lds=8352
.amdgcn_target "amdgcn-amd-amdhsa--gfx950"
.text
.globl standalone__gqa_softmax__sampling_kernel
.p2align 8
.type standalone__gqa_softmax__sampling_kernel,@function
standalone__gqa_softmax__sampling_kernel:
    s_cmpk_ge_u32 s2, 256
    s_cbranch_scc1 L_done
    s_load_dwordx2 s[16:17], s[0:1], 8
    s_memrealtime s[70:71]
    s_load_dwordx2 s[20:21], s[0:1], 16
    s_load_dwordx2 s[24:25], s[0:1], 0
    s_and_b32 s40, s2, 7
    s_lshr_b32 s47, s2, 5
    s_lshl3_add_u32 s40, s47, s40
    s_and_b32 s47, s2, 24
    s_lshl_b32 s43, s40, 21
    s_lshl_b32 s47, s47, 11
    s_or_b32 s43, s43, s47
    s_brev_b32 s18, 16
    s_lshl_b32 s19, 1, 17
    v_readfirstlane_b32 s42, v0
    v_and_b32 v8, 3, v0
    v_and_b32 v9, 0xcc, v0
    v_and_b32 v10, 48, v0
    v_lshlrev_b32 v1, 4, v8
    v_lshl_or_b32 v1, v9, 6, v1
    v_lshl_or_b32 v1, v10, 2, v1
    s_cmpk_ge_u32 s42, 256
    s_cbranch_scc1 L_helper
    s_waitcnt lgkmcnt(0)
    buffer_load_dwordx4 v[58:61], v1, s[16:19], s43 offen nt
    s_mov_b32 s44, s43
    s_addk_i32 s43, 1024
    s_lshr_b32 s42, s42, 6
    v_bfe_u32 v9, v0, 2, 2
    v_lshlrev_b32 v11, 8, v8
    v_lshl_or_b32 v11, v9, 4, v11
    v_lshl_or_b32 v11, v10, 2, v11
    s_lshl_b32 s48, s40, 10
    s_mov_b32 s26, 0x10000
    s_mov_b32 s27, s19
    buffer_load_dwordx4 v[12:15], v11, s[24:27], s48 offen
    v_and_b32 v130, 63, v0
    buffer_load_dwordx4 v[62:65], v1, s[16:19], s43 offen nt
    s_addk_i32 s43, 1024
    v_and_b32 v2, 0xc0, v0
    buffer_load_dwordx4 v[66:69], v1, s[16:19], s43 offen nt
    s_addk_i32 s43, 1024
    v_lshlrev_b32 v130, 4, v130
    buffer_load_dwordx4 v[70:73], v1, s[16:19], s43 offen nt
    s_add_u32 s43, s43, 62464
    s_xor_b32 s43, s43, 0xc000
    v_lshl_or_b32 v2, v2, 6, v130
    s_mov_b32 s22, s18
    s_mov_b32 s23, s19
    buffer_load_dwordx4 v[74:77], v2, s[20:23], s44 offen nt
    s_addk_i32 s44, 1024
    buffer_load_dwordx4 v[78:81], v2, s[20:23], s44 offen nt
    s_addk_i32 s44, 1024
    s_load_dwordx2 s[10:11], s[0:1], 24
    s_load_dwordx4 s[12:15], s[0:1], 32
    s_mov_b32 s45, 0x3e0293ee
    v_mov_b32 v3, 0xff800000
    v_mov_b32 v4, v3
    v_mov_b32 v5, 0
    v_mov_b32 v16, 0
    v_mov_b32 v17, 0
    v_mov_b32 v18, 0
    v_mov_b32 v19, 0
    v_mov_b32 v20, 0
    v_mov_b32 v21, 0
    v_mov_b32 v22, 0
    v_mov_b32 v23, 0
    v_mov_b32 v40, 0
    v_mov_b32 v41, 0
    v_mov_b32 v42, 0
    v_mov_b32 v43, 0
    v_mov_b32 v44, 0
    v_mov_b32 v45, 0
    v_mov_b32 v46, 0
    v_mov_b32 v47, 0
    v_mov_b32 v48, 0
    v_mov_b32 v49, 0
    v_mov_b32 v50, 0
    v_mov_b32 v51, 0
    v_mov_b32 v52, 0
    v_mov_b32 v53, 0
    v_mov_b32 v54, 0
    v_mov_b32 v55, 0
    v_mov_b32 v56, 0
    v_mov_b32 v57, 0
    v_mov_b32 v114, 0
    v_mov_b32 v115, 0
    v_mov_b32 v116, 0
    v_mov_b32 v117, 0
    v_mov_b32 v118, 0
    v_mov_b32 v119, 0
    v_mov_b32 v120, 0
    v_mov_b32 v121, 0
    v_and_b32 v8, 1, v9
    v_lshlrev_b32 v8, 4, v8
    v_mov_b32 v10, 0xffff
    v_lshlrev_b32 v10, v8, v10
    v_cmp_gt_u32 vcc, 2, v9
    s_mov_b32 s46, 16
    s_mov_b32 s49, 0
    v_cndmask_b32 v6, 0, v10, vcc
    v_cndmask_b32 v7, v10, 0, vcc
    s_waitcnt lgkmcnt(0)
    s_add_u32 s72, s70, 70
L_loop:
    s_waitcnt vmcnt(4)
    buffer_load_dwordx4 v[82:85], v2, s[20:23], s44 offen nt
    s_addk_i32 s44, 1024
    v_mfma_f32_16x16x32_bf16 v[24:27], v[58:61], v[12:15], 0
    v_mfma_f32_16x16x32_bf16 v[16:19], v[114:117], v[50:53], v[16:19]
    v_mfma_f32_16x16x32_bf16 v[20:23], v[114:117], v[48:51], v[20:23]
    s_waitcnt vmcnt(4)
    buffer_load_dwordx4 v[86:89], v2, s[20:23], s44 offen nt
    s_add_u32 s44, s44, 62464
    s_xor_b32 s44, s44, 0xc000
    v_mfma_f32_16x16x32_bf16 v[28:31], v[62:65], v[12:15], 0
    v_mfma_f32_16x16x32_bf16 v[16:19], v[118:121], v[54:57], v[16:19]
    v_mfma_f32_16x16x32_bf16 v[20:23], v[118:121], v[52:55], v[20:23]
    s_waitcnt vmcnt(4)
    buffer_load_dwordx4 v[90:93], v1, s[16:19], s43 offen nt
    s_addk_i32 s43, 1024
    v_mfma_f32_16x16x32_bf16 v[32:35], v[66:69], v[12:15], 0
    s_waitcnt vmcnt(4)
    buffer_load_dwordx4 v[94:97], v1, s[16:19], s43 offen nt
    s_addk_i32 s43, 1024
    v_mfma_f32_16x16x32_bf16 v[36:39], v[70:73], v[12:15], 0
    s_waitcnt vmcnt(4)
    buffer_load_dwordx4 v[98:101], v1, s[16:19], s43 offen nt
    s_addk_i32 s43, 1024
    s_nop 3
    v_add_f32_dpp v25, v26, v24 row_ror:8 row_mask:0xf bank_mask:0x1
    v_add_f32_dpp v29, v30, v28 row_ror:8 row_mask:0xf bank_mask:0x1
    v_add_f32_dpp v33, v34, v32 row_ror:8 row_mask:0xf bank_mask:0x1
    v_add_f32_dpp v37, v38, v36 row_ror:8 row_mask:0xf bank_mask:0x1
    v_add_f32_dpp v25, v24, v26 row_ror:8 row_mask:0xf bank_mask:0x4
    v_add_f32_dpp v29, v28, v30 row_ror:8 row_mask:0xf bank_mask:0x4
    v_add_f32_dpp v33, v32, v34 row_ror:8 row_mask:0xf bank_mask:0x4
    v_add_f32_dpp v37, v36, v38 row_ror:8 row_mask:0xf bank_mask:0x4
    v_add_f32_dpp v25, v25, v27 row_ror:8 row_mask:0xf bank_mask:0x8
    v_add_f32_dpp v29, v29, v31 row_ror:8 row_mask:0xf bank_mask:0x8
    v_add_f32_dpp v33, v33, v35 row_ror:8 row_mask:0xf bank_mask:0x8
    v_add_f32_dpp v37, v37, v39 row_ror:8 row_mask:0xf bank_mask:0x8
    v_add_f32_dpp v25, v27, v25 row_ror:8 row_mask:0xf bank_mask:0x2
    v_add_f32_dpp v29, v31, v29 row_ror:8 row_mask:0xf bank_mask:0x2
    v_add_f32_dpp v33, v35, v33 row_ror:8 row_mask:0xf bank_mask:0x2
    v_add_f32_dpp v37, v39, v37 row_ror:8 row_mask:0xf bank_mask:0x2
    v_add_f32_dpp v24, v25, v25 row_ror:4 row_mask:0xf bank_mask:0xf
    v_add_f32_dpp v28, v29, v29 row_ror:4 row_mask:0xf bank_mask:0xf
    v_add_f32_dpp v32, v33, v33 row_ror:4 row_mask:0xf bank_mask:0xf
    v_add_f32_dpp v36, v37, v37 row_ror:4 row_mask:0xf bank_mask:0xf
    s_waitcnt vmcnt(4)
    buffer_load_dwordx4 v[102:105], v1, s[16:19], s43 offen nt
    s_add_u32 s43, s43, 62464
    s_xor_b32 s43, s43, 0xc000
    v_max3_f32 v8, v24, v28, v32
    v_max3_f32 v8, v8, v36, v3
    v_mov_b32 v9, v8
    s_nop 1
    v_permlane32_swap_b32 v8, v9
    s_nop 1
    v_max_f32 v8, v8, v9
    v_mov_b32 v9, v8
    s_nop 1
    v_permlane16_swap_b32 v8, v9
    s_nop 1
    v_max_f32 v3, v8, v9
    v_mul_f32 v11, s45, v3
    v_sub_f32 v10, v4, v11
    v_exp_f32 v10, v10
    v_fma_f32 v24, v24, s45, -v11
    v_fma_f32 v28, v28, s45, -v11
    v_fma_f32 v32, v32, s45, -v11
    v_fma_f32 v36, v36, s45, -v11
    v_exp_f32 v24, v24
    v_exp_f32 v28, v28
    v_exp_f32 v32, v32
    v_exp_f32 v36, v36
    v_mov_b32 v4, v11
    s_waitcnt vmcnt(4)
    buffer_load_dwordx4 v[106:109], v2, s[20:23], s44 offen nt
    s_addk_i32 s44, 1024
    v_mul_f32 v16, v16, v10
    v_mul_f32 v17, v17, v10
    v_mul_f32 v18, v18, v10
    v_mul_f32 v19, v19, v10
    v_mul_f32 v20, v20, v10
    v_mul_f32 v21, v21, v10
    v_mul_f32 v22, v22, v10
    v_mul_f32 v23, v23, v10
    v_cvt_pk_bf16_f32 v25, v24, v24
    v_cvt_pk_bf16_f32 v29, v28, v28
    v_cvt_pk_bf16_f32 v33, v32, v32
    v_cvt_pk_bf16_f32 v37, v36, v36
    v_and_b32 v42, v25, v6
    v_and_b32 v43, v25, v7
    v_and_b32 v46, v29, v6
    v_and_b32 v47, v29, v7
    v_and_b32 v50, v33, v6
    v_and_b32 v51, v33, v7
    v_and_b32 v54, v37, v6
    v_and_b32 v55, v37, v7
    v_fma_f32 v5, v5, v10, v24
    v_add_f32 v28, v28, v32
    v_add_f32 v5, v5, v36
    v_add_f32 v5, v5, v28
    v_mfma_f32_16x16x32_bf16 v[16:19], v[74:77], v[42:45], v[16:19]
    v_mfma_f32_16x16x32_bf16 v[20:23], v[74:77], v[40:43], v[20:23]
    s_waitcnt vmcnt(4)
    buffer_load_dwordx4 v[110:113], v2, s[20:23], s44 offen nt
    s_addk_i32 s44, 1024
    v_mfma_f32_16x16x32_bf16 v[16:19], v[78:81], v[46:49], v[16:19]
    v_mfma_f32_16x16x32_bf16 v[20:23], v[78:81], v[44:47], v[20:23]
    s_waitcnt vmcnt(4)
    buffer_load_dwordx4 v[114:117], v2, s[20:23], s44 offen nt
    s_addk_i32 s44, 1024
    v_mfma_f32_16x16x32_bf16 v[24:27], v[90:93], v[12:15], 0
    v_mfma_f32_16x16x32_bf16 v[16:19], v[82:85], v[50:53], v[16:19]
    v_mfma_f32_16x16x32_bf16 v[20:23], v[82:85], v[48:51], v[20:23]
    s_waitcnt vmcnt(4)
    buffer_load_dwordx4 v[118:121], v2, s[20:23], s44 offen nt
    s_add_u32 s44, s44, 62464
    s_xor_b32 s44, s44, 0xc000
    v_mfma_f32_16x16x32_bf16 v[28:31], v[94:97], v[12:15], 0
    v_mfma_f32_16x16x32_bf16 v[16:19], v[86:89], v[54:57], v[16:19]
    v_mfma_f32_16x16x32_bf16 v[20:23], v[86:89], v[52:55], v[20:23]
    s_waitcnt vmcnt(4)
    buffer_load_dwordx4 v[58:61], v1, s[16:19], s43 offen nt
    s_addk_i32 s43, 1024
    v_mfma_f32_16x16x32_bf16 v[32:35], v[98:101], v[12:15], 0
    s_waitcnt vmcnt(4)
    buffer_load_dwordx4 v[62:65], v1, s[16:19], s43 offen nt
    s_addk_i32 s43, 1024
    v_mfma_f32_16x16x32_bf16 v[36:39], v[102:105], v[12:15], 0
    s_waitcnt vmcnt(4)
    buffer_load_dwordx4 v[66:69], v1, s[16:19], s43 offen nt
    s_addk_i32 s43, 1024
    s_nop 3
    v_add_f32_dpp v25, v26, v24 row_ror:8 row_mask:0xf bank_mask:0x1
    v_add_f32_dpp v29, v30, v28 row_ror:8 row_mask:0xf bank_mask:0x1
    v_add_f32_dpp v33, v34, v32 row_ror:8 row_mask:0xf bank_mask:0x1
    v_add_f32_dpp v37, v38, v36 row_ror:8 row_mask:0xf bank_mask:0x1
    v_add_f32_dpp v25, v24, v26 row_ror:8 row_mask:0xf bank_mask:0x4
    v_add_f32_dpp v29, v28, v30 row_ror:8 row_mask:0xf bank_mask:0x4
    v_add_f32_dpp v33, v32, v34 row_ror:8 row_mask:0xf bank_mask:0x4
    v_add_f32_dpp v37, v36, v38 row_ror:8 row_mask:0xf bank_mask:0x4
    v_add_f32_dpp v25, v25, v27 row_ror:8 row_mask:0xf bank_mask:0x8
    v_add_f32_dpp v29, v29, v31 row_ror:8 row_mask:0xf bank_mask:0x8
    v_add_f32_dpp v33, v33, v35 row_ror:8 row_mask:0xf bank_mask:0x8
    v_add_f32_dpp v37, v37, v39 row_ror:8 row_mask:0xf bank_mask:0x8
    v_add_f32_dpp v25, v27, v25 row_ror:8 row_mask:0xf bank_mask:0x2
    v_add_f32_dpp v29, v31, v29 row_ror:8 row_mask:0xf bank_mask:0x2
    v_add_f32_dpp v33, v35, v33 row_ror:8 row_mask:0xf bank_mask:0x2
    v_add_f32_dpp v37, v39, v37 row_ror:8 row_mask:0xf bank_mask:0x2
    v_add_f32_dpp v24, v25, v25 row_ror:4 row_mask:0xf bank_mask:0xf
    v_add_f32_dpp v28, v29, v29 row_ror:4 row_mask:0xf bank_mask:0xf
    v_add_f32_dpp v32, v33, v33 row_ror:4 row_mask:0xf bank_mask:0xf
    v_add_f32_dpp v36, v37, v37 row_ror:4 row_mask:0xf bank_mask:0xf
    s_waitcnt vmcnt(4)
    buffer_load_dwordx4 v[70:73], v1, s[16:19], s43 offen nt
    s_add_u32 s43, s43, 62464
    s_xor_b32 s43, s43, 0xc000
    v_max3_f32 v8, v24, v28, v32
    v_max3_f32 v8, v8, v36, v3
    v_mov_b32 v9, v8
    s_nop 1
    v_permlane32_swap_b32 v8, v9
    s_nop 1
    v_max_f32 v8, v8, v9
    v_mov_b32 v9, v8
    s_nop 1
    v_permlane16_swap_b32 v8, v9
    s_nop 1
    v_max_f32 v3, v8, v9
    v_mul_f32 v11, s45, v3
    v_sub_f32 v10, v4, v11
    v_exp_f32 v10, v10
    v_fma_f32 v24, v24, s45, -v11
    v_fma_f32 v28, v28, s45, -v11
    v_fma_f32 v32, v32, s45, -v11
    v_fma_f32 v36, v36, s45, -v11
    v_exp_f32 v24, v24
    v_exp_f32 v28, v28
    v_exp_f32 v32, v32
    v_exp_f32 v36, v36
    v_mov_b32 v4, v11
    s_memrealtime s[70:71]
    s_waitcnt vmcnt(4)
    buffer_load_dwordx4 v[74:77], v2, s[20:23], s44 offen nt
    s_addk_i32 s44, 1024
    v_mul_f32 v16, v16, v10
    v_mul_f32 v17, v17, v10
    v_mul_f32 v18, v18, v10
    v_mul_f32 v19, v19, v10
    v_mul_f32 v20, v20, v10
    v_mul_f32 v21, v21, v10
    v_mul_f32 v22, v22, v10
    v_mul_f32 v23, v23, v10
    v_cvt_pk_bf16_f32 v25, v24, v24
    v_cvt_pk_bf16_f32 v29, v28, v28
    v_cvt_pk_bf16_f32 v33, v32, v32
    v_cvt_pk_bf16_f32 v37, v36, v36
    v_and_b32 v42, v25, v6
    v_and_b32 v43, v25, v7
    v_and_b32 v46, v29, v6
    v_and_b32 v47, v29, v7
    v_and_b32 v50, v33, v6
    v_and_b32 v51, v33, v7
    v_and_b32 v54, v37, v6
    v_and_b32 v55, v37, v7
    v_fma_f32 v5, v5, v10, v24
    v_add_f32 v28, v28, v32
    v_add_f32 v5, v5, v36
    v_add_f32 v5, v5, v28
    v_mfma_f32_16x16x32_bf16 v[16:19], v[106:109], v[42:45], v[16:19]
    v_mfma_f32_16x16x32_bf16 v[20:23], v[106:109], v[40:43], v[20:23]
    s_waitcnt vmcnt(4)
    buffer_load_dwordx4 v[78:81], v2, s[20:23], s44 offen nt
    s_addk_i32 s44, 1024
    v_mfma_f32_16x16x32_bf16 v[16:19], v[110:113], v[46:49], v[16:19]
    v_mfma_f32_16x16x32_bf16 v[20:23], v[110:113], v[44:47], v[20:23]
    s_sub_u32 s46, s46, 1
    s_cmp_eq_u32 s46, 1
    s_cbranch_scc1 L_last
    s_add_u32 s72, s72, 217
    s_waitcnt lgkmcnt(0)
    s_sub_u32 s47, s70, s72
    s_cmp_gt_i32 s47, 0
    s_cbranch_scc0 L_loop
L_loopB:
    s_waitcnt vmcnt(5)
    buffer_load_dwordx4 v[82:85], v2, s[20:23], s44 offen nt
    s_addk_i32 s44, 1024
    v_mfma_f32_16x16x32_bf16 v[24:27], v[58:61], v[12:15], 0
    v_mfma_f32_16x16x32_bf16 v[16:19], v[114:117], v[50:53], v[16:19]
    v_mfma_f32_16x16x32_bf16 v[20:23], v[114:117], v[48:51], v[20:23]
    s_waitcnt vmcnt(5)
    buffer_load_dwordx4 v[86:89], v2, s[20:23], s44 offen nt
    s_add_u32 s44, s44, 62464
    s_xor_b32 s44, s44, 0xc000
    v_mfma_f32_16x16x32_bf16 v[28:31], v[62:65], v[12:15], 0
    v_mfma_f32_16x16x32_bf16 v[16:19], v[118:121], v[54:57], v[16:19]
    v_mfma_f32_16x16x32_bf16 v[20:23], v[118:121], v[52:55], v[20:23]
    s_waitcnt vmcnt(5)
    buffer_load_dwordx4 v[90:93], v1, s[16:19], s43 offen nt
    s_addk_i32 s43, 1024
    v_mfma_f32_16x16x32_bf16 v[32:35], v[66:69], v[12:15], 0
    s_waitcnt vmcnt(5)
    buffer_load_dwordx4 v[94:97], v1, s[16:19], s43 offen nt
    s_addk_i32 s43, 1024
    v_mfma_f32_16x16x32_bf16 v[36:39], v[70:73], v[12:15], 0
    s_waitcnt vmcnt(5)
    buffer_load_dwordx4 v[98:101], v1, s[16:19], s43 offen nt
    s_addk_i32 s43, 1024
    s_nop 3
    v_add_f32_dpp v25, v26, v24 row_ror:8 row_mask:0xf bank_mask:0x1
    v_add_f32_dpp v29, v30, v28 row_ror:8 row_mask:0xf bank_mask:0x1
    v_add_f32_dpp v33, v34, v32 row_ror:8 row_mask:0xf bank_mask:0x1
    v_add_f32_dpp v37, v38, v36 row_ror:8 row_mask:0xf bank_mask:0x1
    v_add_f32_dpp v25, v24, v26 row_ror:8 row_mask:0xf bank_mask:0x4
    v_add_f32_dpp v29, v28, v30 row_ror:8 row_mask:0xf bank_mask:0x4
    v_add_f32_dpp v33, v32, v34 row_ror:8 row_mask:0xf bank_mask:0x4
    v_add_f32_dpp v37, v36, v38 row_ror:8 row_mask:0xf bank_mask:0x4
    v_add_f32_dpp v25, v25, v27 row_ror:8 row_mask:0xf bank_mask:0x8
    v_add_f32_dpp v29, v29, v31 row_ror:8 row_mask:0xf bank_mask:0x8
    v_add_f32_dpp v33, v33, v35 row_ror:8 row_mask:0xf bank_mask:0x8
    v_add_f32_dpp v37, v37, v39 row_ror:8 row_mask:0xf bank_mask:0x8
    v_add_f32_dpp v25, v27, v25 row_ror:8 row_mask:0xf bank_mask:0x2
    v_add_f32_dpp v29, v31, v29 row_ror:8 row_mask:0xf bank_mask:0x2
    v_add_f32_dpp v33, v35, v33 row_ror:8 row_mask:0xf bank_mask:0x2
    v_add_f32_dpp v37, v39, v37 row_ror:8 row_mask:0xf bank_mask:0x2
    v_add_f32_dpp v24, v25, v25 row_ror:4 row_mask:0xf bank_mask:0xf
    v_add_f32_dpp v28, v29, v29 row_ror:4 row_mask:0xf bank_mask:0xf
    v_add_f32_dpp v32, v33, v33 row_ror:4 row_mask:0xf bank_mask:0xf
    v_add_f32_dpp v36, v37, v37 row_ror:4 row_mask:0xf bank_mask:0xf
    s_waitcnt vmcnt(5)
    buffer_load_dwordx4 v[102:105], v1, s[16:19], s43 offen nt
    s_add_u32 s43, s43, 62464
    s_xor_b32 s43, s43, 0xc000
    v_max3_f32 v8, v24, v28, v32
    v_max3_f32 v8, v8, v36, v3
    v_mov_b32 v9, v8
    s_nop 1
    v_permlane32_swap_b32 v8, v9
    s_nop 1
    v_max_f32 v8, v8, v9
    v_mov_b32 v9, v8
    s_nop 1
    v_permlane16_swap_b32 v8, v9
    s_nop 1
    v_max_f32 v3, v8, v9
    v_mul_f32 v11, s45, v3
    v_sub_f32 v10, v4, v11
    v_exp_f32 v10, v10
    v_fma_f32 v24, v24, s45, -v11
    v_fma_f32 v28, v28, s45, -v11
    v_fma_f32 v32, v32, s45, -v11
    v_fma_f32 v36, v36, s45, -v11
    v_exp_f32 v24, v24
    v_exp_f32 v28, v28
    v_exp_f32 v32, v32
    v_exp_f32 v36, v36
    v_mov_b32 v4, v11
    s_waitcnt vmcnt(5)
    buffer_load_dwordx4 v[106:109], v2, s[20:23], s44 offen nt
    s_addk_i32 s44, 1024
    v_mul_f32 v16, v16, v10
    v_mul_f32 v17, v17, v10
    v_mul_f32 v18, v18, v10
    v_mul_f32 v19, v19, v10
    v_mul_f32 v20, v20, v10
    v_mul_f32 v21, v21, v10
    v_mul_f32 v22, v22, v10
    v_mul_f32 v23, v23, v10
    v_cvt_pk_bf16_f32 v25, v24, v24
    v_cvt_pk_bf16_f32 v29, v28, v28
    v_cvt_pk_bf16_f32 v33, v32, v32
    v_cvt_pk_bf16_f32 v37, v36, v36
    v_and_b32 v42, v25, v6
    v_and_b32 v43, v25, v7
    v_and_b32 v46, v29, v6
    v_and_b32 v47, v29, v7
    v_and_b32 v50, v33, v6
    v_and_b32 v51, v33, v7
    v_and_b32 v54, v37, v6
    v_and_b32 v55, v37, v7
    v_fma_f32 v5, v5, v10, v24
    v_add_f32 v28, v28, v32
    v_add_f32 v5, v5, v36
    v_add_f32 v5, v5, v28
    v_mfma_f32_16x16x32_bf16 v[16:19], v[74:77], v[42:45], v[16:19]
    v_mfma_f32_16x16x32_bf16 v[20:23], v[74:77], v[40:43], v[20:23]
    s_waitcnt vmcnt(5)
    buffer_load_dwordx4 v[110:113], v2, s[20:23], s44 offen nt
    s_addk_i32 s44, 1024
    v_mfma_f32_16x16x32_bf16 v[16:19], v[78:81], v[46:49], v[16:19]
    v_mfma_f32_16x16x32_bf16 v[20:23], v[78:81], v[44:47], v[20:23]
    s_waitcnt vmcnt(5)
    buffer_load_dwordx4 v[114:117], v2, s[20:23], s44 offen nt
    s_addk_i32 s44, 1024
    v_mfma_f32_16x16x32_bf16 v[24:27], v[90:93], v[12:15], 0
    v_mfma_f32_16x16x32_bf16 v[16:19], v[82:85], v[50:53], v[16:19]
    v_mfma_f32_16x16x32_bf16 v[20:23], v[82:85], v[48:51], v[20:23]
    s_waitcnt vmcnt(5)
    buffer_load_dwordx4 v[118:121], v2, s[20:23], s44 offen nt
    s_add_u32 s44, s44, 62464
    s_xor_b32 s44, s44, 0xc000
    v_mfma_f32_16x16x32_bf16 v[28:31], v[94:97], v[12:15], 0
    v_mfma_f32_16x16x32_bf16 v[16:19], v[86:89], v[54:57], v[16:19]
    v_mfma_f32_16x16x32_bf16 v[20:23], v[86:89], v[52:55], v[20:23]
    s_waitcnt vmcnt(5)
    buffer_load_dwordx4 v[58:61], v1, s[16:19], s43 offen nt
    s_addk_i32 s43, 1024
    v_mfma_f32_16x16x32_bf16 v[32:35], v[98:101], v[12:15], 0
    s_waitcnt vmcnt(5)
    buffer_load_dwordx4 v[62:65], v1, s[16:19], s43 offen nt
    s_addk_i32 s43, 1024
    v_mfma_f32_16x16x32_bf16 v[36:39], v[102:105], v[12:15], 0
    s_waitcnt vmcnt(5)
    buffer_load_dwordx4 v[66:69], v1, s[16:19], s43 offen nt
    s_addk_i32 s43, 1024
    s_nop 3
    v_add_f32_dpp v25, v26, v24 row_ror:8 row_mask:0xf bank_mask:0x1
    v_add_f32_dpp v29, v30, v28 row_ror:8 row_mask:0xf bank_mask:0x1
    v_add_f32_dpp v33, v34, v32 row_ror:8 row_mask:0xf bank_mask:0x1
    v_add_f32_dpp v37, v38, v36 row_ror:8 row_mask:0xf bank_mask:0x1
    v_add_f32_dpp v25, v24, v26 row_ror:8 row_mask:0xf bank_mask:0x4
    v_add_f32_dpp v29, v28, v30 row_ror:8 row_mask:0xf bank_mask:0x4
    v_add_f32_dpp v33, v32, v34 row_ror:8 row_mask:0xf bank_mask:0x4
    v_add_f32_dpp v37, v36, v38 row_ror:8 row_mask:0xf bank_mask:0x4
    v_add_f32_dpp v25, v25, v27 row_ror:8 row_mask:0xf bank_mask:0x8
    v_add_f32_dpp v29, v29, v31 row_ror:8 row_mask:0xf bank_mask:0x8
    v_add_f32_dpp v33, v33, v35 row_ror:8 row_mask:0xf bank_mask:0x8
    v_add_f32_dpp v37, v37, v39 row_ror:8 row_mask:0xf bank_mask:0x8
    v_add_f32_dpp v25, v27, v25 row_ror:8 row_mask:0xf bank_mask:0x2
    v_add_f32_dpp v29, v31, v29 row_ror:8 row_mask:0xf bank_mask:0x2
    v_add_f32_dpp v33, v35, v33 row_ror:8 row_mask:0xf bank_mask:0x2
    v_add_f32_dpp v37, v39, v37 row_ror:8 row_mask:0xf bank_mask:0x2
    v_add_f32_dpp v24, v25, v25 row_ror:4 row_mask:0xf bank_mask:0xf
    v_add_f32_dpp v28, v29, v29 row_ror:4 row_mask:0xf bank_mask:0xf
    v_add_f32_dpp v32, v33, v33 row_ror:4 row_mask:0xf bank_mask:0xf
    v_add_f32_dpp v36, v37, v37 row_ror:4 row_mask:0xf bank_mask:0xf
    s_waitcnt vmcnt(5)
    buffer_load_dwordx4 v[70:73], v1, s[16:19], s43 offen nt
    s_add_u32 s43, s43, 62464
    s_xor_b32 s43, s43, 0xc000
    v_max3_f32 v8, v24, v28, v32
    v_max3_f32 v8, v8, v36, v3
    v_mov_b32 v9, v8
    s_nop 1
    v_permlane32_swap_b32 v8, v9
    s_nop 1
    v_max_f32 v8, v8, v9
    v_mov_b32 v9, v8
    s_nop 1
    v_permlane16_swap_b32 v8, v9
    s_nop 1
    v_max_f32 v3, v8, v9
    v_mul_f32 v11, s45, v3
    v_sub_f32 v10, v4, v11
    v_exp_f32 v10, v10
    v_fma_f32 v24, v24, s45, -v11
    v_fma_f32 v28, v28, s45, -v11
    v_fma_f32 v32, v32, s45, -v11
    v_fma_f32 v36, v36, s45, -v11
    v_exp_f32 v24, v24
    v_exp_f32 v28, v28
    v_exp_f32 v32, v32
    v_exp_f32 v36, v36
    v_mov_b32 v4, v11
    s_memrealtime s[70:71]
    s_waitcnt vmcnt(5)
    buffer_load_dwordx4 v[74:77], v2, s[20:23], s44 offen nt
    s_addk_i32 s44, 1024
    v_mul_f32 v16, v16, v10
    v_mul_f32 v17, v17, v10
    v_mul_f32 v18, v18, v10
    v_mul_f32 v19, v19, v10
    v_mul_f32 v20, v20, v10
    v_mul_f32 v21, v21, v10
    v_mul_f32 v22, v22, v10
    v_mul_f32 v23, v23, v10
    v_cvt_pk_bf16_f32 v25, v24, v24
    v_cvt_pk_bf16_f32 v29, v28, v28
    v_cvt_pk_bf16_f32 v33, v32, v32
    v_cvt_pk_bf16_f32 v37, v36, v36
    v_and_b32 v42, v25, v6
    v_and_b32 v43, v25, v7
    v_and_b32 v46, v29, v6
    v_and_b32 v47, v29, v7
    v_and_b32 v50, v33, v6
    v_and_b32 v51, v33, v7
    v_and_b32 v54, v37, v6
    v_and_b32 v55, v37, v7
    v_fma_f32 v5, v5, v10, v24
    v_add_f32 v28, v28, v32
    v_add_f32 v5, v5, v36
    v_add_f32 v5, v5, v28
    v_mfma_f32_16x16x32_bf16 v[16:19], v[106:109], v[42:45], v[16:19]
    v_mfma_f32_16x16x32_bf16 v[20:23], v[106:109], v[40:43], v[20:23]
    s_waitcnt vmcnt(5)
    buffer_load_dwordx4 v[78:81], v2, s[20:23], s44 offen nt
    s_addk_i32 s44, 1024
    v_mfma_f32_16x16x32_bf16 v[16:19], v[110:113], v[46:49], v[16:19]
    v_mfma_f32_16x16x32_bf16 v[20:23], v[110:113], v[44:47], v[20:23]
    s_sub_u32 s46, s46, 1
    s_cmp_eq_u32 s46, 1
    s_cbranch_scc1 L_last
    s_add_u32 s72, s72, 217
    s_waitcnt lgkmcnt(0)
    s_sub_u32 s47, s70, s72
    s_cmp_gt_i32 s47, 0
    s_cbranch_scc1 L_loopB
    s_branch L_loop
L_last:
    buffer_load_dwordx4 v[82:85], v2, s[20:23], s44 offen nt
    s_addk_i32 s44, 1024
    buffer_load_dwordx4 v[86:89], v2, s[20:23], s44 offen nt
    s_add_u32 s44, s44, 62464
    s_xor_b32 s44, s44, 0xc000
    s_waitcnt lgkmcnt(0)
    s_lshl_b32 s47, s40, 2
    s_add_u32 s60, s12, s47
    s_addc_u32 s61, s13, 0
    s_load_dword s49, s[60:61], 0x0
    s_mov_b32 s28, s14
    s_mov_b32 s29, s15
    s_mov_b32 s30, 2097152
    s_mov_b32 s31, 0x20000
    s_add_u32 s32, s10, s48
    s_addc_u32 s33, s11, 0
    s_movk_i32 s34, 1024
    s_mov_b32 s35, 0x20000
    s_mov_b32 s36, s12
    s_mov_b32 s37, s13
    s_movk_i32 s38, 256
    s_mov_b32 s39, 0x20000
    s_lshl_b32 s62, s2, 12
    s_xor_b32 s63, s62, 32768
    s_xor_b32 s64, s62, 65536
    s_xor_b32 s65, s62, 98304
    s_getreg_b32 s68, hwreg(HW_REG_XCC_ID, 0, 4)
    s_mul_i32 s47, s68, 3
    s_lshl_b32 s47, 4, s47
    s_cmp_gt_u32 s68, 7
    s_cselect_b32 s68, -1, s47
    v_lshlrev_b32 v122, 3, v0
    v_bfe_u32 v127, v0, 1, 2
    s_lshl_b32 s47, s42, 5
    v_lshl_add_u32 v123, v127, 3, s47
    v_lshlrev_b32 v124, 8, v127
    v_lshlrev_b32 v127, 5, v127
    v_bfe_u32 v129, v0, 5, 2
    v_lshl_add_u32 v124, v129, 6, v124
    v_and_b32 v129, 1, v0
    v_lshl_add_u32 v124, v129, 5, v124
    v_bfe_u32 v129, v0, 7, 1
    v_lshl_add_u32 v124, v129, 3, v124
    v_bfe_u32 v129, v0, 3, 2
    v_lshl_add_u32 v124, v129, 1, v124
    v_mov_b32 v129, 0
    s_lshl_b32 s47, s42, 11
    v_add_u32 v125, s47, v130
    s_lshl_b32 s47, s42, 3
    v_lshl_add_u32 v126, v130, 1, s47
    s_lshl_b32 s47, s42, 2
    v_mov_b32 v128, s47
    s_lshl_b32 s47, s42, 15
    s_xor_b32 s47, s47, s62
    v_lshlrev_b32 v8, 2, v130
    v_min_u32 v8, 0x840, v8
    buffer_load_dword v131, v8, s[28:31], s47 offen sc1
    s_waitcnt vmcnt(8)
    buffer_load_dwordx4 v[90:93], v1, s[16:19], s43 offen nt
    s_addk_i32 s43, 1024
    v_mfma_f32_16x16x32_bf16 v[24:27], v[58:61], v[12:15], 0
    v_mfma_f32_16x16x32_bf16 v[16:19], v[114:117], v[50:53], v[16:19]
    v_mfma_f32_16x16x32_bf16 v[20:23], v[114:117], v[48:51], v[20:23]
    s_waitcnt vmcnt(8)
    buffer_load_dwordx4 v[94:97], v1, s[16:19], s43 offen nt
    s_addk_i32 s43, 1024
    v_mfma_f32_16x16x32_bf16 v[28:31], v[62:65], v[12:15], 0
    v_mfma_f32_16x16x32_bf16 v[16:19], v[118:121], v[54:57], v[16:19]
    v_mfma_f32_16x16x32_bf16 v[20:23], v[118:121], v[52:55], v[20:23]
    s_waitcnt vmcnt(8)
    buffer_load_dwordx4 v[98:101], v1, s[16:19], s43 offen nt
    s_addk_i32 s43, 1024
    v_mfma_f32_16x16x32_bf16 v[32:35], v[66:69], v[12:15], 0
    s_waitcnt vmcnt(8)
    buffer_load_dwordx4 v[102:105], v1, s[16:19], s43 offen nt
    s_add_u32 s43, s43, 62464
    s_xor_b32 s43, s43, 0xc000
    v_mfma_f32_16x16x32_bf16 v[36:39], v[70:73], v[12:15], 0
    s_nop 4
    v_add_f32_dpp v25, v26, v24 row_ror:8 row_mask:0xf bank_mask:0x1
    v_add_f32_dpp v29, v30, v28 row_ror:8 row_mask:0xf bank_mask:0x1
    v_add_f32_dpp v33, v34, v32 row_ror:8 row_mask:0xf bank_mask:0x1
    v_add_f32_dpp v37, v38, v36 row_ror:8 row_mask:0xf bank_mask:0x1
    v_add_f32_dpp v25, v24, v26 row_ror:8 row_mask:0xf bank_mask:0x4
    v_add_f32_dpp v29, v28, v30 row_ror:8 row_mask:0xf bank_mask:0x4
    v_add_f32_dpp v33, v32, v34 row_ror:8 row_mask:0xf bank_mask:0x4
    v_add_f32_dpp v37, v36, v38 row_ror:8 row_mask:0xf bank_mask:0x4
    v_add_f32_dpp v25, v25, v27 row_ror:8 row_mask:0xf bank_mask:0x8
    v_add_f32_dpp v29, v29, v31 row_ror:8 row_mask:0xf bank_mask:0x8
    v_add_f32_dpp v33, v33, v35 row_ror:8 row_mask:0xf bank_mask:0x8
    v_add_f32_dpp v37, v37, v39 row_ror:8 row_mask:0xf bank_mask:0x8
    v_add_f32_dpp v25, v27, v25 row_ror:8 row_mask:0xf bank_mask:0x2
    v_add_f32_dpp v29, v31, v29 row_ror:8 row_mask:0xf bank_mask:0x2
    v_add_f32_dpp v33, v35, v33 row_ror:8 row_mask:0xf bank_mask:0x2
    v_add_f32_dpp v37, v39, v37 row_ror:8 row_mask:0xf bank_mask:0x2
    v_add_f32_dpp v24, v25, v25 row_ror:4 row_mask:0xf bank_mask:0xf
    v_add_f32_dpp v28, v29, v29 row_ror:4 row_mask:0xf bank_mask:0xf
    v_add_f32_dpp v32, v33, v33 row_ror:4 row_mask:0xf bank_mask:0xf
    v_add_f32_dpp v36, v37, v37 row_ror:4 row_mask:0xf bank_mask:0xf
    v_max3_f32 v8, v24, v28, v32
    v_max3_f32 v8, v8, v36, v3
    v_mov_b32 v9, v8
    s_nop 1
    v_permlane32_swap_b32 v8, v9
    s_nop 1
    v_max_f32 v8, v8, v9
    v_mov_b32 v9, v8
    s_nop 1
    v_permlane16_swap_b32 v8, v9
    s_nop 1
    v_max_f32 v3, v8, v9
    v_mul_f32 v11, s45, v3
    v_sub_f32 v10, v4, v11
    v_exp_f32 v10, v10
    v_fma_f32 v24, v24, s45, -v11
    v_fma_f32 v28, v28, s45, -v11
    v_fma_f32 v32, v32, s45, -v11
    v_fma_f32 v36, v36, s45, -v11
    v_exp_f32 v24, v24
    v_exp_f32 v28, v28
    v_exp_f32 v32, v32
    v_exp_f32 v36, v36
    v_mov_b32 v4, v11
    v_mul_f32 v16, v16, v10
    v_mul_f32 v17, v17, v10
    v_mul_f32 v18, v18, v10
    v_mul_f32 v19, v19, v10
    v_mul_f32 v20, v20, v10
    v_mul_f32 v21, v21, v10
    v_mul_f32 v22, v22, v10
    v_mul_f32 v23, v23, v10
    v_cvt_pk_bf16_f32 v25, v24, v24
    v_cvt_pk_bf16_f32 v29, v28, v28
    v_cvt_pk_bf16_f32 v33, v32, v32
    v_cvt_pk_bf16_f32 v37, v36, v36
    v_and_b32 v42, v25, v6
    v_and_b32 v43, v25, v7
    v_and_b32 v46, v29, v6
    v_and_b32 v47, v29, v7
    v_and_b32 v50, v33, v6
    v_and_b32 v51, v33, v7
    v_and_b32 v54, v37, v6
    v_and_b32 v55, v37, v7
    v_fma_f32 v5, v5, v10, v24
    v_add_f32 v28, v28, v32
    v_add_f32 v5, v5, v36
    v_add_f32 v5, v5, v28
    s_waitcnt vmcnt(8)
    buffer_load_dwordx4 v[106:109], v2, s[20:23], s44 offen nt
    s_addk_i32 s44, 1024
    v_mfma_f32_16x16x32_bf16 v[16:19], v[74:77], v[42:45], v[16:19]
    v_mfma_f32_16x16x32_bf16 v[20:23], v[74:77], v[40:43], v[20:23]
    s_waitcnt vmcnt(8)
    buffer_load_dwordx4 v[110:113], v2, s[20:23], s44 offen nt
    s_addk_i32 s44, 1024
    v_mfma_f32_16x16x32_bf16 v[16:19], v[78:81], v[46:49], v[16:19]
    v_mfma_f32_16x16x32_bf16 v[20:23], v[78:81], v[44:47], v[20:23]
    s_waitcnt vmcnt(8)
    buffer_load_dwordx4 v[114:117], v2, s[20:23], s44 offen nt
    s_addk_i32 s44, 1024
    v_mfma_f32_16x16x32_bf16 v[16:19], v[82:85], v[50:53], v[16:19]
    v_mfma_f32_16x16x32_bf16 v[20:23], v[82:85], v[48:51], v[20:23]
    s_waitcnt vmcnt(8)
    buffer_load_dwordx4 v[118:121], v2, s[20:23], s44 offen nt
    s_add_u32 s44, s44, 62464
    s_xor_b32 s44, s44, 0xc000
    v_mfma_f32_16x16x32_bf16 v[16:19], v[86:89], v[54:57], v[16:19]
    v_mfma_f32_16x16x32_bf16 v[20:23], v[86:89], v[52:55], v[20:23]
    s_waitcnt vmcnt(7)
    v_mfma_f32_16x16x32_bf16 v[24:27], v[90:93], v[12:15], 0
    s_waitcnt vmcnt(6)
    v_mfma_f32_16x16x32_bf16 v[28:31], v[94:97], v[12:15], 0
    s_waitcnt vmcnt(5)
    v_mfma_f32_16x16x32_bf16 v[32:35], v[98:101], v[12:15], 0
    s_waitcnt vmcnt(4)
    v_mfma_f32_16x16x32_bf16 v[36:39], v[102:105], v[12:15], 0
    s_nop 4
    v_add_f32_dpp v25, v26, v24 row_ror:8 row_mask:0xf bank_mask:0x1
    v_add_f32_dpp v29, v30, v28 row_ror:8 row_mask:0xf bank_mask:0x1
    v_add_f32_dpp v33, v34, v32 row_ror:8 row_mask:0xf bank_mask:0x1
    v_add_f32_dpp v37, v38, v36 row_ror:8 row_mask:0xf bank_mask:0x1
    v_add_f32_dpp v25, v24, v26 row_ror:8 row_mask:0xf bank_mask:0x4
    v_add_f32_dpp v29, v28, v30 row_ror:8 row_mask:0xf bank_mask:0x4
    v_add_f32_dpp v33, v32, v34 row_ror:8 row_mask:0xf bank_mask:0x4
    v_add_f32_dpp v37, v36, v38 row_ror:8 row_mask:0xf bank_mask:0x4
    v_add_f32_dpp v25, v25, v27 row_ror:8 row_mask:0xf bank_mask:0x8
    v_add_f32_dpp v29, v29, v31 row_ror:8 row_mask:0xf bank_mask:0x8
    v_add_f32_dpp v33, v33, v35 row_ror:8 row_mask:0xf bank_mask:0x8
    v_add_f32_dpp v37, v37, v39 row_ror:8 row_mask:0xf bank_mask:0x8
    v_add_f32_dpp v25, v27, v25 row_ror:8 row_mask:0xf bank_mask:0x2
    v_add_f32_dpp v29, v31, v29 row_ror:8 row_mask:0xf bank_mask:0x2
    v_add_f32_dpp v33, v35, v33 row_ror:8 row_mask:0xf bank_mask:0x2
    v_add_f32_dpp v37, v39, v37 row_ror:8 row_mask:0xf bank_mask:0x2
    v_add_f32_dpp v24, v25, v25 row_ror:4 row_mask:0xf bank_mask:0xf
    v_add_f32_dpp v28, v29, v29 row_ror:4 row_mask:0xf bank_mask:0xf
    v_add_f32_dpp v32, v33, v33 row_ror:4 row_mask:0xf bank_mask:0xf
    v_add_f32_dpp v36, v37, v37 row_ror:4 row_mask:0xf bank_mask:0xf
    v_max3_f32 v8, v24, v28, v32
    v_max3_f32 v8, v8, v36, v3
    v_mov_b32 v9, v8
    s_nop 1
    v_permlane32_swap_b32 v8, v9
    s_nop 1
    v_max_f32 v8, v8, v9
    v_mov_b32 v9, v8
    s_nop 1
    v_permlane16_swap_b32 v8, v9
    s_nop 1
    v_max_f32 v3, v8, v9
    v_mul_f32 v11, s45, v3
    v_sub_f32 v10, v4, v11
    v_exp_f32 v10, v10
    v_fma_f32 v24, v24, s45, -v11
    v_fma_f32 v28, v28, s45, -v11
    v_fma_f32 v32, v32, s45, -v11
    v_fma_f32 v36, v36, s45, -v11
    v_exp_f32 v24, v24
    v_exp_f32 v28, v28
    v_exp_f32 v32, v32
    v_exp_f32 v36, v36
    v_mov_b32 v4, v11
    v_mul_f32 v16, v16, v10
    v_mul_f32 v17, v17, v10
    v_mul_f32 v18, v18, v10
    v_mul_f32 v19, v19, v10
    v_mul_f32 v20, v20, v10
    v_mul_f32 v21, v21, v10
    v_mul_f32 v22, v22, v10
    v_mul_f32 v23, v23, v10
    v_cvt_pk_bf16_f32 v25, v24, v24
    v_cvt_pk_bf16_f32 v29, v28, v28
    v_cvt_pk_bf16_f32 v33, v32, v32
    v_cvt_pk_bf16_f32 v37, v36, v36
    v_and_b32 v42, v25, v6
    v_and_b32 v43, v25, v7
    v_and_b32 v46, v29, v6
    v_and_b32 v47, v29, v7
    v_and_b32 v50, v33, v6
    v_and_b32 v51, v33, v7
    v_and_b32 v54, v37, v6
    v_and_b32 v55, v37, v7
    v_fma_f32 v5, v5, v10, v24
    v_add_f32 v28, v28, v32
    v_add_f32 v5, v5, v36
    v_add_f32 v5, v5, v28
    v_mov_b32 v9, v5
    s_waitcnt lgkmcnt(0)
    s_and_b32 s49, s49, 0xffffff
    v_permlane32_swap_b32 v5, v9
    s_cmp_eq_u32 s49, s68
    s_cselect_b32 s67, 1, 0
    v_add_f32 v5, v5, v9
    v_mov_b32 v9, v5
    v_mov_b32 v3, s67
    s_nop 0
    v_permlane16_swap_b32 v5, v9
    s_nop 1
    v_add_f32 v5, v5, v9
    s_mov_b64 exec, 0xf
    ds_write_b64 v126, v[4:5] offset:8192
    ds_write_b32 v128, v3 offset:8320
    s_mov_b64 exec, -1
    s_nop 3
    s_waitcnt vmcnt(3)
    v_mfma_f32_16x16x32_bf16 v[16:19], v[106:109], v[42:45], v[16:19]
    v_mfma_f32_16x16x32_bf16 v[20:23], v[106:109], v[40:43], v[20:23]
    s_waitcnt vmcnt(2)
    v_mfma_f32_16x16x32_bf16 v[16:19], v[110:113], v[46:49], v[16:19]
    v_mfma_f32_16x16x32_bf16 v[20:23], v[110:113], v[44:47], v[20:23]
    s_waitcnt vmcnt(1)
    v_mfma_f32_16x16x32_bf16 v[16:19], v[114:117], v[50:53], v[16:19]
    v_mfma_f32_16x16x32_bf16 v[20:23], v[114:117], v[48:51], v[20:23]
    s_waitcnt vmcnt(0)
    v_mfma_f32_16x16x32_bf16 v[16:19], v[118:121], v[54:57], v[16:19]
    v_mfma_f32_16x16x32_bf16 v[20:23], v[118:121], v[52:55], v[20:23]
    s_nop 7
    ds_write_b128 v125, v[16:19]
    ds_write_b128 v125, v[20:23] offset:1024
    s_waitcnt lgkmcnt(0)
    s_barrier
    ds_read_b128 v[40:43], v127 offset:8192
    ds_read_b128 v[44:47], v127 offset:8208
    ds_read_b128 v[12:15], v129 offset:8320
    ds_read_b64 v[48:49], v122 offset:0
    ds_read_b64 v[50:51], v122 offset:2048
    ds_read_b64 v[52:53], v122 offset:4096
    ds_read_b64 v[54:55], v122 offset:6144
    s_mov_b32 s47, 0xfffffffe
    s_waitcnt lgkmcnt(4)
    v_max_f32 v38, v40, v42
    v_and_b32 v12, v12, v13
    v_max3_f32 v38, v38, v44, v46
    v_and_b32 v14, v14, v15
    v_sub_f32 v40, v40, v38
    v_sub_f32 v42, v42, v38
    v_sub_f32 v44, v44, v38
    v_sub_f32 v46, v46, v38
    v_and_b32 v12, v12, v14
    v_exp_f32 v40, v40
    v_exp_f32 v42, v42
    v_exp_f32 v44, v44
    v_exp_f32 v46, v46
    v_readfirstlane_b32 s67, v12
    v_mul_f32 v39, v40, v41
    v_fmac_f32 v39, v42, v43
    v_fmac_f32 v39, v44, v45
    v_fmac_f32 v39, v46, v47
    s_waitcnt lgkmcnt(0)
    v_mul_f32 v36, v40, v48
    v_mul_f32 v37, v40, v49
    v_fmac_f32 v36, v42, v50
    v_fmac_f32 v37, v42, v51
    v_fmac_f32 v36, v44, v52
    v_fmac_f32 v37, v44, v53
    v_fmac_f32 v36, v46, v54
    v_fmac_f32 v37, v46, v55
    v_min_u32 v38, s47, v38
    v_min_u32 v39, s47, v39
    v_min_u32 v36, s47, v36
    v_min_u32 v37, s47, v37
    s_cmp_eq_u32 s67, 0
    s_cbranch_scc1 L_slow
    buffer_store_dwordx2 v[36:37], v122, s[28:31], s62 offen
    s_mov_b64 exec, 0x55
    buffer_store_dwordx2 v[38:39], v123, s[28:31], s62 offen offset:2048
    s_mov_b64 exec, -1
    buffer_load_dwordx2 v[24:25], v122, s[28:31], s63 offen sc1
    buffer_load_dwordx2 v[26:27], v123, s[28:31], s63 offen offset:2048 sc1
    buffer_load_dwordx2 v[28:29], v122, s[28:31], s64 offen sc1
    buffer_load_dwordx2 v[30:31], v123, s[28:31], s64 offen offset:2048 sc1
    buffer_load_dwordx2 v[32:33], v122, s[28:31], s65 offen sc1
    buffer_load_dwordx2 v[34:35], v123, s[28:31], s65 offen offset:2048 sc1
    s_waitcnt vmcnt(0)
    v_max3_u32 v8, v24, v25, v26
    v_max3_u32 v9, v27, v28, v29
    v_max3_u32 v8, v8, v30, v31
    v_max3_u32 v9, v9, v32, v33
    v_max3_u32 v8, v8, v34, v35
    v_max_u32 v8, v8, v9
    v_cmp_eq_u32 vcc, -1, v8
    s_cbranch_vccz L_final
L_round2:
    buffer_load_dwordx2 v[24:25], v122, s[28:31], s63 offen sc1
    buffer_load_dwordx2 v[26:27], v123, s[28:31], s63 offen offset:2048 sc1
    buffer_load_dwordx2 v[28:29], v122, s[28:31], s64 offen sc1
    buffer_load_dwordx2 v[30:31], v123, s[28:31], s64 offen offset:2048 sc1
    buffer_load_dwordx2 v[32:33], v122, s[28:31], s65 offen sc1
    buffer_load_dwordx2 v[34:35], v123, s[28:31], s65 offen offset:2048 sc1
    s_waitcnt vmcnt(0)
    v_max3_u32 v8, v24, v25, v26
    v_max3_u32 v9, v27, v28, v29
    v_max3_u32 v8, v8, v30, v31
    v_max3_u32 v9, v9, v32, v33
    v_max3_u32 v8, v8, v34, v35
    v_max_u32 v8, v8, v9
    v_cmp_eq_u32 vcc, -1, v8
    s_cbranch_vccz L_final
    s_branch L_fin
L_slow:
    buffer_store_dwordx2 v[36:37], v122, s[28:31], s62 offen
    s_mov_b64 exec, 0x55
    buffer_store_dwordx2 v[38:39], v123, s[28:31], s62 offen offset:2048
    s_mov_b64 exec, -1
    s_add_u32 s47, s62, 1048576
    buffer_store_dwordx2 v[36:37], v122, s[28:31], s47 offen sc1
    s_mov_b64 exec, 0x55
    buffer_store_dwordx2 v[38:39], v123, s[28:31], s47 offen offset:2048 sc1
    s_mov_b64 exec, -1
    s_waitcnt vmcnt(0)
    s_barrier
    s_cmp_lg_u32 s42, 0
    s_cbranch_scc1 L_noatom
    s_mov_b64 exec, 1
    v_mov_b32 v8, 0x1000000
    s_lshl_b32 s47, s40, 2
    buffer_atomic_add v8, v129, s[36:39], s47 offen sc0
    s_waitcnt vmcnt(0)
    ds_write_b32 v129, v8 offset:8336
    s_mov_b64 exec, -1
    s_waitcnt lgkmcnt(0)
L_noatom:
    s_barrier
    ds_read_b32 v8, v129 offset:8336
    s_waitcnt lgkmcnt(0)
    v_readfirstlane_b32 s49, v8
    s_nop 3
    s_and_b32 s47, s49, 0xffffff
    s_cmp_eq_u32 s47, s68
    s_cbranch_scc1 L_round2
    s_lshr_b32 s47, s49, 24
    s_cmp_lg_u32 s47, 3
    s_cbranch_scc1 L_fin
    s_add_u32 s47, s63, 1048576
    buffer_load_dwordx2 v[24:25], v122, s[28:31], s47 offen sc1
    buffer_load_dwordx2 v[26:27], v123, s[28:31], s47 offen offset:2048 sc1
    s_add_u32 s47, s64, 1048576
    buffer_load_dwordx2 v[28:29], v122, s[28:31], s47 offen sc1
    buffer_load_dwordx2 v[30:31], v123, s[28:31], s47 offen offset:2048 sc1
    s_add_u32 s47, s65, 1048576
    buffer_load_dwordx2 v[32:33], v122, s[28:31], s47 offen sc1
    buffer_load_dwordx2 v[34:35], v123, s[28:31], s47 offen offset:2048 sc1
    s_waitcnt vmcnt(0)
L_final:
    v_max_f32 v4, v38, v26
    v_max3_f32 v4, v4, v30, v34
    v_sub_f32 v38, v38, v4
    v_sub_f32 v26, v26, v4
    v_sub_f32 v30, v30, v4
    v_sub_f32 v34, v34, v4
    v_exp_f32 v38, v38
    v_exp_f32 v26, v26
    v_exp_f32 v30, v30
    v_exp_f32 v34, v34
    s_nop 0
    v_mul_f32 v39, v39, v38
    v_mul_f32 v27, v27, v26
    v_mul_f32 v31, v31, v30
    v_mul_f32 v35, v35, v34
    v_mul_f32 v36, v36, v38
    v_mul_f32 v24, v24, v26
    v_mul_f32 v28, v28, v30
    v_mul_f32 v32, v32, v34
    v_mul_f32 v37, v37, v38
    v_mul_f32 v25, v25, v26
    v_mul_f32 v29, v29, v30
    v_mul_f32 v33, v33, v34
    v_add_f32 v39, v39, v27
    v_add_f32 v31, v31, v35
    v_add_f32 v36, v36, v24
    v_add_f32 v28, v28, v32
    v_add_f32 v37, v37, v25
    v_add_f32 v29, v29, v33
    v_add_f32 v39, v39, v31
    v_rcp_f32 v5, v39
    v_add_f32 v36, v36, v28
    v_add_f32 v37, v37, v29
    v_mul_f32 v36, v36, v5
    v_mul_f32 v37, v37, v5
    v_cvt_pk_bf16_f32 v36, v36, v37
    buffer_store_short v36, v124, s[32:35], 0 offen
    buffer_store_short_d16_hi v36, v124, s[32:35], 0 offen offset:16
L_fin:
L_done:
    s_endpgm
L_helper:
    s_load_dwordx4 s[12:15], s[0:1], 32
    s_getreg_b32 s68, hwreg(HW_REG_XCC_ID, 0, 4)
    v_and_b32 v2, 63, v0
    v_lshlrev_b32 v2, 4, v2
    v_mov_b32 v24, -1
    v_mov_b32 v25, -1
    v_mov_b32 v26, -1
    v_mov_b32 v27, -1
    s_cmp_gt_u32 s68, 7
    s_cbranch_scc1 L_done
    s_mul_i32 s68, s68, 3
    s_lshl_b32 s68, 1, s68
    s_lshl_b32 s47, s40, 2
    s_lshl_b32 s62, s2, 12
    s_mov_b32 s30, 2097152
    s_mov_b32 s31, 0x20000
    s_waitcnt lgkmcnt(0)
    s_mov_b32 s28, s14
    s_mov_b32 s29, s15
    buffer_store_dwordx4 v[24:27], v2, s[28:31], s62 offen offset:0
    buffer_store_dwordx4 v[24:27], v2, s[28:31], s62 offen offset:1024
    s_mov_b64 exec, 0xff
    buffer_store_dwordx4 v[24:27], v2, s[28:31], s62 offen offset:2048
    s_add_u32 s60, s12, s47
    s_addc_u32 s61, s13, 0
    s_waitcnt vmcnt(0)
    s_atomic_add s68, s[60:61], 0x0
    s_endpgm
L_codeend:
.section .rodata,"a"
.p2align 6
.amdhsa_kernel standalone__gqa_softmax__sampling_kernel
  .amdhsa_next_free_vgpr 132
  .amdhsa_next_free_sgpr 92
  .amdhsa_accum_offset 132
  .amdhsa_group_segment_fixed_size 0
  .amdhsa_kernarg_size 48
  .amdhsa_user_sgpr_count 2
  .amdhsa_user_sgpr_kernarg_segment_ptr 1
  .amdhsa_system_sgpr_workgroup_id_x 1
.end_amdhsa_kernel
```
